```python
import torch

def _softmax(x, axis=-1):
    return torch.softmax(x, dim=axis)
def _gelu(x):
    return torch.nn.functional.gelu(x, approximate="tanh")
def _silu(x):
    return torch.nn.functional.silu(x)
def _sigmoid(x):
    return torch.sigmoid(x)
def _layernorm(x, axis=-1, eps=1e-5):
    m = x.mean(dim=axis, keepdim=True)
    v = x.var(dim=axis, keepdim=True, unbiased=False)
    return (x - m) / torch.sqrt(v + eps)
def _scatter_add(tgt, idx, src, axis=0):
    return tgt.clone().index_add_(axis, idx, src)
def _segment_sum(src, seg, n):
    out = torch.zeros((n,) + src.shape[1:], dtype=src.dtype)
    return out.index_add_(0, seg, src)
def _pad(x, pw):
    flat = tuple(v for pair in reversed(pw) for v in pair)
    return torch.nn.functional.pad(x, flat)

kernel_name = 'standalone__gqa_softmax__sampling'

def setup_inputs():

    _w = (lambda a: (lambda t: t.to(torch.bfloat16) if t.is_floating_point() else t)(torch.as_tensor(a)))
    B, Hq, Hkv, Sq, Sk, D = 8, 32, 8, 8, 8192, 128
    return {
        "q": _w((lambda *s: torch.randn(*s, dtype=torch.bfloat16) * 0.8)(B, Hq, Sq, D)),
        "k": _w((lambda *s: torch.randn(*s, dtype=torch.bfloat16) * 0.8)(B, Hkv, Sk, D)),
        "v": _w((lambda *s: torch.randn(*s, dtype=torch.bfloat16) * 0.05)(B, Hkv, Sk, D)),
    }

def reference(q, k, v):
    B, Hq, Sq, D = q.shape
    Hkv = k.shape[1]
    rep = Hq // Hkv
    k = (lambda x, n, axis: torch.repeat_interleave(x, n, dim=axis))(k, rep, axis=1)
    v = (lambda x, n, axis: torch.repeat_interleave(x, n, dim=axis))(v, rep, axis=1)
    scale = D ** -0.5
    scores = torch.einsum("bhqd,bhkd->bhqk", q, k) * scale
    p = _softmax(scores, axis=-1)
    return torch.einsum("bhqk,bhkd->bhqd", p, v)
```

```asm
; @launch grid=(256,1,1) block=(256,1,1) lds=160768
.amdgcn_target "amdgcn-amd-amdhsa--gfx950"
.text
.globl standalone__gqa_softmax__sampling_kernel
.p2align 8
.type standalone__gqa_softmax__sampling_kernel,@function
standalone__gqa_softmax__sampling_kernel:
  s_load_dwordx2 s[16:17], s[0:1], 8
  s_load_dwordx8 s[8:15], s[0:1], 16
  v_readfirstlane_b32 s40, v0
  s_cmpk_ge_u32 s2, 256
  s_cbranch_scc1 L_end
  s_and_b32 s41, s2, 63
  s_lshr_b32 s42, s2, 6
  s_cmp_lg_u32 s40, 0
  s_cbranch_scc1 L_cons
  v_lshrrev_b32 v2, 4, v0
  v_xor_b32 v3, v2, v0
  v_xor_b32 v4, 4, v3
  v_xor_b32 v5, 8, v3
  v_xor_b32 v6, 12, v3
  v_lshlrev_b32 v3, 4, v3
  v_lshlrev_b32 v4, 4, v4
  v_lshlrev_b32 v5, 4, v5
  v_lshlrev_b32 v6, 4, v6
  s_lshl_b32 s34, s41, 8
  s_add_u32 s43, s34, s42
  s_lshl_b32 s43, s43, 13
  s_and_b32 s37, s2, 16
  s_lshl_b32 s37, s37, 8
  s_xor_b32 s43, s43, s37
  s_bfm_b32 s18, 1, 27
  s_mov_b32 s19, 0x20000
  s_mov_b32 s48, 0
  s_mov_b32 s44, 0
  s_mov_b32 s35, 4
  v_mov_b32 v9, -8
  v_mov_b32 v7, 0
  v_lshlrev_b32 v8, 2, v0
  v_add_u32 v8, 159744, v8
  s_waitcnt lgkmcnt(0)
L_ld_go:
  s_add_u32 m0, s48, 0
  s_waitcnt vmcnt(19)
  buffer_load_dwordx4 v3, s[16:19], s43 offen offset:0 nt lds
  s_waitcnt vmcnt(19)
  buffer_load_dwordx4 v4, s[16:19], s43 offen offset:1024 nt lds
  s_waitcnt vmcnt(19)
  buffer_load_dwordx4 v5, s[16:19], s43 offen offset:2048 nt lds
  s_waitcnt vmcnt(19)
  buffer_load_dwordx4 v6, s[16:19], s43 offen offset:3072 nt lds
  s_sub_i32 s49, s44, 2
  v_max_i32 v9, s49, v9
  ds_write_b32 v8, v9
  s_add_u32 m0, s48, 4096
  s_xor_b32 s43, s43, 0x1000
  s_waitcnt vmcnt(19)
  buffer_load_dwordx4 v3, s[16:19], s43 offen offset:0 nt lds
  s_waitcnt vmcnt(19)
  buffer_load_dwordx4 v4, s[16:19], s43 offen offset:1024 nt lds
  s_waitcnt vmcnt(19)
  buffer_load_dwordx4 v5, s[16:19], s43 offen offset:2048 nt lds
  ds_read2_b32 v[10:11], v8 offset0:64 offset1:128
  ds_read_b32 v14, v8 offset:768
  s_waitcnt vmcnt(19)
  buffer_load_dwordx4 v6, s[16:19], s43 offen offset:3072 nt lds
L_ld_next:
  s_add_u32 s44, s44, 1
  s_and_b32 s49, s44, 63
  s_lshl2_add_u32 s43, s49, s34
  s_add_u32 s49, s44, s42
  s_and_b32 s49, s49, 3
  s_add_u32 s43, s43, s49
  s_lshl_b32 s43, s43, 13
  s_xor_b32 s43, s43, s37
  s_addk_i32 s48, 8192
  s_cmp_eq_u32 s48, 57344
  s_cselect_b32 s48, 0, s48
  s_cmp_lt_u32 s44, 4
  s_cbranch_scc1 L_ld_go
  s_cmp_lg_u32 s44, s35
  s_cbranch_scc1 L_ld
  s_cmp_gt_u32 s44, 4
  s_cbranch_scc1 L_ld_ev2
  s_mov_b32 s35, 64
  s_mov_b32 s57, 0
  s_waitcnt lgkmcnt(0)
  s_barrier
  s_branch L_ld_go
L_ld:
  s_waitcnt lgkmcnt(0)
  v_min_i32 v10, v10, v11
  v_readfirstlane_b32 s50, v14
  v_readfirstlane_b32 s49, v10
  s_sub_i32 s51, s44, 6
  s_cmp_lt_i32 s49, s51
  s_cbranch_scc1 L_ld_full
  s_sub_u32 s49, s44, 64
  s_cmp_lt_u32 s49, 4
  s_cselect_b32 s50, 2, s50
  s_cmp_eq_u32 s50, 0
  s_cbranch_scc1 L_ld_go
  s_cmp_eq_u32 s50, 1
  s_cbranch_scc1 L_ld_wide
  s_add_u32 m0, s48, 0
  s_waitcnt vmcnt(17)
  buffer_load_dwordx4 v3, s[16:19], s43 offen offset:0 nt lds
  s_waitcnt vmcnt(17)
  buffer_load_dwordx4 v4, s[16:19], s43 offen offset:1024 nt lds
  s_sub_i32 s49, s44, 2
  v_max_i32 v9, s49, v9
  ds_write_b32 v8, v9
  s_waitcnt vmcnt(17)
  buffer_load_dwordx4 v5, s[16:19], s43 offen offset:2048 nt lds
  s_waitcnt vmcnt(17)
  buffer_load_dwordx4 v6, s[16:19], s43 offen offset:3072 nt lds
  s_add_u32 m0, s48, 4096
  s_xor_b32 s43, s43, 0x1000
  s_waitcnt vmcnt(17)
  buffer_load_dwordx4 v3, s[16:19], s43 offen offset:0 nt lds
  s_waitcnt vmcnt(17)
  buffer_load_dwordx4 v4, s[16:19], s43 offen offset:1024 nt lds
  s_waitcnt vmcnt(17)
  buffer_load_dwordx4 v5, s[16:19], s43 offen offset:2048 nt lds
  ds_read2_b32 v[10:11], v8 offset0:64 offset1:128
  ds_read_b32 v14, v8 offset:768
  s_waitcnt vmcnt(17)
  buffer_load_dwordx4 v6, s[16:19], s43 offen offset:3072 nt lds
  s_branch L_ld_next
L_ld_wide:
  s_add_u32 m0, s48, 0
  s_waitcnt vmcnt(23)
  buffer_load_dwordx4 v3, s[16:19], s43 offen offset:0 nt lds
  s_waitcnt vmcnt(23)
  buffer_load_dwordx4 v4, s[16:19], s43 offen offset:1024 nt lds
  s_waitcnt vmcnt(23)
  buffer_load_dwordx4 v5, s[16:19], s43 offen offset:2048 nt lds
  s_waitcnt vmcnt(23)
  buffer_load_dwordx4 v6, s[16:19], s43 offen offset:3072 nt lds
  s_add_u32 m0, s48, 4096
  s_xor_b32 s43, s43, 0x1000
  s_waitcnt vmcnt(23)
  buffer_load_dwordx4 v3, s[16:19], s43 offen offset:0 nt lds
  s_waitcnt vmcnt(23)
  buffer_load_dwordx4 v4, s[16:19], s43 offen offset:1024 nt lds
  s_waitcnt vmcnt(23)
  buffer_load_dwordx4 v5, s[16:19], s43 offen offset:2048 nt lds
  s_waitcnt vmcnt(23)
  buffer_load_dwordx4 v6, s[16:19], s43 offen offset:3072 nt lds
  s_sub_i32 s49, s44, 2
  v_max_i32 v9, s49, v9
  ds_write_b32 v8, v9
  ds_read2_b32 v[10:11], v8 offset0:64 offset1:128
  ds_read_b32 v14, v8 offset:768
  s_branch L_ld_next
L_ld_full:
  ds_read2_b32 v[10:11], v8 offset0:64 offset1:128
  s_add_u32 s57, s57, 1
  s_cmp_lt_u32 s57, 0x4000000
  s_cbranch_scc1 L_ld
  s_endpgm
L_ld_ev2:
  s_cmp_lg_u32 s44, 64
  s_cbranch_scc1 L_ld_end
  s_mov_b64 s[16:17], s[8:9]
  v_mov_b32 v4, v3
  v_mov_b32 v5, v3
  v_mov_b32 v6, v3
  s_mov_b32 s35, 128
  s_mul_i32 s49, s41, 34816
  s_mul_i32 s50, s42, 4352
  s_add_u32 s49, s49, s50
  s_add_u32 s49, s49, 1048576
  v_bfe_u32 v15, v0, 2, 2
  v_cmp_ne_u32 vcc, s42, v15
  v_and_b32 v15, 3, v0
  v_or_b32 v15, 64, v15
  v_cndmask_b32 v15, v15, v0, vcc
  v_lshl_add_u32 v2, v15, 6, s49
  v_add_u32 v7, 17408, v2
  v_and_b32 v15, 1, v0
  v_cmp_eq_u32 vcc, 0, v15
  s_nop 1
  v_cndmask_b32 v0, v7, v2, vcc
  s_branch L_ld
L_ld_end:
  s_mov_b32 s36, s14
  s_and_b32 s37, s15, 0xffff
  s_mov_b32 s38, 0x1000000
  s_mov_b32 s39, 0x20000
  buffer_load_dword v16, v2, s[36:39], 0 offen nt
  buffer_load_dword v17, v7, s[36:39], 0 offen nt
  buffer_load_dword v18, v0, s[36:39], 0 offen sc1
  s_waitcnt vmcnt(19)
  v_max_i32 v9, 126, v9
  ds_write_b32 v8, v9
  s_waitcnt vmcnt(11)
  v_max_i32 v9, 127, v9
  ds_write_b32 v8, v9
  s_waitcnt vmcnt(3)
  s_barrier
  s_endpgm
L_cons:
  s_cmp_lg_u32 s40, 192
  s_cbranch_scc1 L_cons1
  s_barrier
  s_branch L_mon
L_cons1:
  s_load_dwordx2 s[4:5], s[0:1], 0
  v_and_b32 v0, 63, v0
  v_lshrrev_b32 v2, 4, v0
  v_and_b32 v1, 15, v0
  s_lshr_b32 s40, s40, 7
  v_lshlrev_b32 v3, 8, v1
  v_lshl_add_u32 v3, v2, 4, v3
  s_lshl_b32 s33, s41, 13
  s_lshl_b32 s49, s40, 12
  s_add_u32 s33, s33, s49
  s_mov_b32 s26, 0x80000
  s_mov_b32 s27, 0x20000
  s_lshl_b32 s49, s40, 8
  s_add_u32 s49, s49, 160000
  v_lshl_add_u32 v200, v0, 2, s49
  v_mov_b32 v11, 0
  ds_write_b32 v200, v11
  ds_write_b32 v200, v11 offset:256
  s_waitcnt lgkmcnt(0)
  s_mov_b32 s24, s4
  s_and_b32 s25, s5, 0xffff
  buffer_load_dwordx4 v[52:55], v3, s[24:27], s33 offen offset:0 nt
  buffer_load_dwordx4 v[56:59], v3, s[24:27], s33 offen offset:64 nt
  buffer_load_dwordx4 v[60:63], v3, s[24:27], s33 offen offset:128 nt
  buffer_load_dwordx4 v[64:67], v3, s[24:27], s33 offen offset:192 nt
  s_mov_b32 s28, s10
  s_and_b32 s29, s11, 0xffff
  s_mov_b32 s30, 0x80000
  s_mov_b32 s31, 0x20000
  s_mov_b32 s36, s14
  s_and_b32 s37, s15, 0xffff
  s_mov_b32 s38, 0x1000000
  s_mov_b32 s39, 0x20000
  s_mov_b32 s45, 0x3e0293ee
  s_mov_b32 s46, 0xbe0293ee
  s_lshl_b32 s49, s41, 1
  s_add_u32 s49, s49, s40
  s_lshl_b32 s56, s49, 7
  s_add_u32 s56, s56, 524288
  s_mov_b64 exec, 1
  buffer_load_dwordx2 v[202:203], off, s[36:39], s56 nt
  s_mov_b64 exec, -1
  s_mul_i32 s49, s49, 17408
  s_add_u32 s60, s49, 1048576
  s_add_u32 s61, s60, 4096
  s_mul_i32 s50, s42, 4352
  s_add_u32 s74, s60, s50
  s_add_u32 s75, s74, 4096
  s_getreg_b32 s59, hwreg(HW_REG_XCC_ID)
  s_and_b32 s59, s59, 15
  v_xor_b32 v12, v1, v2
  v_lshlrev_b32 v12, 4, v12
  v_lshl_add_u32 v12, v1, 8, v12
  v_xor_b32 v13, 64, v12
  v_xor_b32 v14, 128, v12
  v_xor_b32 v15, 192, v12
  v_lshrrev_b32 v5, 2, v0
  v_and_b32 v6, 3, v5
  v_and_b32 v11, 3, v0
  v_lshl_add_u32 v16, v11, 2, v6
  v_lshlrev_b32 v16, 4, v16
  v_lshl_add_u32 v16, v5, 8, v16
  v_xor_b32 v17, 16, v16
  v_xor_b32 v18, 32, v16
  v_xor_b32 v19, 48, v16
  v_lshlrev_b32 v197, 4, v0
  v_lshlrev_b32 v201, 4, v11
  v_lshl_add_u32 v201, v2, 6, v201
  v_lshl_add_u32 v196, v6, 8, v201
  s_lshl_b32 s49, s42, 8
  v_add_u32 v201, s49, v201
  v_lshl_add_u32 v201, v6, 10, v201
  v_subrev_u32 v7, 0, v6
  v_and_b32 v7, 3, v7
  v_cmp_ne_u32 s[66:67], s42, v7
  v_mul_u32_u24 v7, 4352, v7
  v_add_u32 v208, v201, v7
  v_subrev_u32 v7, 1, v6
  v_and_b32 v7, 3, v7
  v_cmp_ne_u32 s[68:69], s42, v7
  v_mul_u32_u24 v7, 4352, v7
  v_add_u32 v209, v201, v7
  v_subrev_u32 v7, 2, v6
  v_and_b32 v7, 3, v7
  v_cmp_ne_u32 s[70:71], s42, v7
  v_mul_u32_u24 v7, 4352, v7
  v_add_u32 v210, v201, v7
  v_subrev_u32 v7, 3, v6
  v_and_b32 v7, 3, v7
  v_cmp_ne_u32 s[72:73], s42, v7
  v_mul_u32_u24 v7, 4352, v7
  v_add_u32 v211, v201, v7
  s_lshl_b32 s49, s42, 2
  v_add_u32 v7, s49, v11
  v_lshlrev_b32 v7, 4, v7
  v_mul_u32_u24 v199, 4352, v6
  v_add_u32 v199, v199, v7
  v_mov_b32 v7, 0x2000000
  v_cndmask_b32 v196, v7, v196, s[66:67]
  v_lshlrev_b32 v198, 8, v11
  v_lshl_add_u32 v198, v5, 4, v198
  s_lshl_b32 s49, s42, 10
  s_add_u32 s33, s33, s49
  v_mov_b32 v3, 0xff800000
  v_mov_b32 v4, 0
  v_mov_b32 v7, 0x7f800000
  s_mul_i32 s49, s40, 49152
  s_add_u32 s49, s49, 57344
  v_add_u32 v204, s49, v197
  s_lshl_b32 s49, s40, 11
  s_add_u32 s49, s49, 155648
  v_lshl_add_u32 v205, v1, 2, s49
  v_mov_b32 v20, v12
  v_mov_b32 v21, v13
  v_mov_b32 v22, v14
  v_mov_b32 v23, v15
  v_add_u32 v24, 8192, v12
  v_add_u32 v25, 8192, v13
  v_add_u32 v26, 8192, v14
  v_add_u32 v27, 8192, v15
  v_mov_b32 v10, 159744
  v_mov_b32 v201, 0
  s_mov_b32 s44, 0
  s_mov_b32 s57, 0
  s_mov_b32 s48, 8192
  s_mov_b32 s51, 2
  s_mov_b32 s63, 0
  s_mov_b32 s32, 0
  s_barrier
  s_waitcnt vmcnt(1)
L_p1:
  s_waitcnt lgkmcnt(0)
  v_readfirstlane_b32 s58, v201
  s_cmp_ge_i32 s58, s51
  s_cbranch_scc1 L_wk_ok
L_wk:
  ds_read_b32 v201, v10
  s_add_u32 s63, s63, 1
  s_cmp_gt_u32 s63, 0x4000000
  s_cbranch_scc1 L_end
  s_waitcnt lgkmcnt(0)
  v_readfirstlane_b32 s58, v201
  s_cmp_lt_i32 s58, s51
  s_cbranch_scc1 L_wk
L_wk_ok:
  ds_read_b128 v[68:71], v20 offset:0
  ds_read_b128 v[84:87], v20 offset:4096
  ds_read_b128 v[72:75], v21 offset:0
  ds_read_b128 v[88:91], v21 offset:4096
  ds_read_b128 v[76:79], v22 offset:0
  ds_read_b128 v[92:95], v22 offset:4096
  ds_read_b128 v[80:83], v23 offset:0
  ds_read_b128 v[96:99], v23 offset:4096
  ds_read_b128 v[100:103], v24 offset:0
  ds_read_b128 v[116:119], v24 offset:4096
  ds_read_b128 v[104:107], v25 offset:0
  ds_read_b128 v[120:123], v25 offset:4096
  ds_read_b128 v[108:111], v26 offset:0
  ds_read_b128 v[124:127], v26 offset:4096
  s_waitcnt lgkmcnt(13)
  ds_read_b128 v[112:115], v27 offset:0
  ds_read_b128 v[128:131], v27 offset:4096
  v_mov_b32 v11, s51
  s_add_u32 s51, s51, 2
  s_waitcnt lgkmcnt(14)
  v_mfma_f32_16x16x32_bf16 v[28:31], v[68:71], v[52:55], 0
  v_mfma_f32_16x16x32_bf16 v[32:35], v[84:87], v[52:55], 0
  s_waitcnt lgkmcnt(12)
  v_mfma_f32_16x16x32_bf16 v[28:31], v[72:75], v[56:59], v[28:31]
  v_mfma_f32_16x16x32_bf16 v[32:35], v[88:91], v[56:59], v[32:35]
  s_waitcnt lgkmcnt(10)
  v_mfma_f32_16x16x32_bf16 v[28:31], v[76:79], v[60:63], v[28:31]
  v_mfma_f32_16x16x32_bf16 v[32:35], v[92:95], v[60:63], v[32:35]
  s_waitcnt lgkmcnt(8)
  v_mfma_f32_16x16x32_bf16 v[28:31], v[80:83], v[64:67], v[28:31]
  v_mfma_f32_16x16x32_bf16 v[32:35], v[96:99], v[64:67], v[32:35]
  s_waitcnt lgkmcnt(6)
  v_mfma_f32_16x16x32_bf16 v[36:39], v[100:103], v[52:55], 0
  v_mfma_f32_16x16x32_bf16 v[40:43], v[116:119], v[52:55], 0
  s_waitcnt lgkmcnt(4)
  v_mfma_f32_16x16x32_bf16 v[36:39], v[104:107], v[56:59], v[36:39]
  v_mfma_f32_16x16x32_bf16 v[40:43], v[120:123], v[56:59], v[40:43]
  s_waitcnt lgkmcnt(2)
  v_mfma_f32_16x16x32_bf16 v[36:39], v[108:111], v[60:63], v[36:39]
  v_mfma_f32_16x16x32_bf16 v[40:43], v[124:127], v[60:63], v[40:43]
  s_waitcnt lgkmcnt(0)
  ds_write_b32 v200, v11
  v_mfma_f32_16x16x32_bf16 v[36:39], v[112:115], v[64:67], v[36:39]
  v_mfma_f32_16x16x32_bf16 v[40:43], v[128:131], v[64:67], v[40:43]
  v_max3_f32 v5, v28, v29, v3
  v_max3_f32 v6, v30, v31, v32
  v_max3_f32 v5, v5, v33, v34
  s_add_u32 s48, s48, 8192
  s_cmp_eq_u32 s48, 57344
  s_cselect_b32 s48, 0, s48
  v_add_u32 v20, s48, v12
  v_add_u32 v21, s48, v13
  v_add_u32 v22, s48, v14
  v_add_u32 v23, s48, v15
  s_add_u32 s48, s48, 8192
  s_cmp_eq_u32 s48, 57344
  s_cselect_b32 s48, 0, s48
  v_add_u32 v24, s48, v12
  v_add_u32 v25, s48, v13
  v_add_u32 v26, s48, v14
  v_add_u32 v27, s48, v15
  v_max3_f32 v6, v6, v35, v36
  v_max3_f32 v5, v5, v37, v38
  v_max3_f32 v6, v6, v39, v40
  v_max3_f32 v5, v5, v41, v42
  v_max3_f32 v5, v5, v6, v43
  v_mov_b32 v6, v5
  s_nop 1
  v_permlane32_swap_b32 v5, v6
  v_max_f32 v5, v5, v6
  v_mov_b32 v6, v5
  s_nop 1
  v_permlane16_swap_b32 v5, v6
  v_max_f32 v5, v5, v6
  v_mul_f32 v6, s46, v5
  v_cmp_neq_f32 vcc, v3, v5
  v_sub_f32 v8, v6, v7
  v_mov_b32 v7, v6
  v_mov_b32 v3, v5
  v_exp_f32 v8, v8
  v_fma_f32 v28, v28, s45, v6
  v_fma_f32 v29, v29, s45, v6
  v_fma_f32 v30, v30, s45, v6
  v_fma_f32 v31, v31, s45, v6
  v_fma_f32 v32, v32, s45, v6
  v_fma_f32 v33, v33, s45, v6
  v_fma_f32 v34, v34, s45, v6
  v_fma_f32 v35, v35, s45, v6
  v_fma_f32 v36, v36, s45, v6
  v_fma_f32 v37, v37, s45, v6
  v_fma_f32 v38, v38, s45, v6
  v_fma_f32 v39, v39, s45, v6
  v_fma_f32 v40, v40, s45, v6
  v_fma_f32 v41, v41, s45, v6
  v_fma_f32 v42, v42, s45, v6
  v_fma_f32 v43, v43, s45, v6
  s_cbranch_vccz L_noal
  s_bitset1_b32 s32, s44
  s_mov_b64 exec, 0xffff
  ds_write_b32 v205, v8
  s_mov_b64 exec, -1
  v_mul_f32 v4, v4, v8
L_noal:
  v_exp_f32 v28, v28
  v_exp_f32 v29, v29
  v_exp_f32 v30, v30
  v_exp_f32 v31, v31
  v_exp_f32 v32, v32
  v_exp_f32 v33, v33
  v_exp_f32 v34, v34
  v_exp_f32 v35, v35
  v_exp_f32 v36, v36
  v_exp_f32 v37, v37
  v_exp_f32 v38, v38
  v_exp_f32 v39, v39
  v_exp_f32 v40, v40
  v_exp_f32 v41, v41
  v_exp_f32 v42, v42
  v_exp_f32 v43, v43
  v_add_u32 v205, 64, v205
  v_cvt_pk_bf16_f32 v44, v28, v29
  v_cvt_pk_bf16_f32 v45, v30, v31
  v_cvt_pk_bf16_f32 v46, v32, v33
  v_cvt_pk_bf16_f32 v47, v34, v35
  v_cvt_pk_bf16_f32 v48, v36, v37
  v_cvt_pk_bf16_f32 v49, v38, v39
  v_cvt_pk_bf16_f32 v50, v40, v41
  v_cvt_pk_bf16_f32 v51, v42, v43
  ds_read_b32 v201, v10
  s_cmp_ge_u32 s44, 24
  s_cbranch_scc1 L_preg
  ds_write_b128 v204, v[44:47]
  ds_write_b128 v204, v[48:51] offset:1024
  v_add_u32 v204, 2048, v204
  s_branch L_pdone
L_preg:
  s_sub_u32 s35, s44, 24
  s_lshl_b32 s35, s35, 3
  s_set_gpr_idx_on s35, gpr_idx(DST)
  s_nop 0
  v_mov_b32 v132, v44
  v_mov_b32 v133, v45
  v_mov_b32 v134, v46
  v_mov_b32 v135, v47
  v_mov_b32 v136, v48
  v_mov_b32 v137, v49
  v_mov_b32 v138, v50
  v_mov_b32 v139, v51
  s_set_gpr_idx_off
L_pdone:
  v_pk_add_f32 v[28:29], v[28:29], v[36:37]
  v_pk_add_f32 v[30:31], v[30:31], v[38:39]
  v_pk_add_f32 v[32:33], v[32:33], v[40:41]
  v_pk_add_f32 v[34:35], v[34:35], v[42:43]
  v_pk_add_f32 v[28:29], v[28:29], v[32:33]
  v_pk_add_f32 v[30:31], v[30:31], v[34:35]
  s_add_u32 s44, s44, 1
  v_pk_add_f32 v[28:29], v[28:29], v[30:31]
  s_cmp_lt_u32 s44, 32
  v_add_f32 v4, v4, v28
  v_add_f32 v4, v4, v29
  s_cbranch_scc1 L_p1
  v_mov_b32 v6, v4
  s_waitcnt vmcnt(0)
  v_readfirstlane_b32 s52, v202
  v_permlane32_swap_b32 v4, v6
  v_readfirstlane_b32 s53, v203
  v_add_f32 v4, v4, v6
  v_mov_b32 v6, v4
  s_add_u32 s52, s52, 128
  s_addc_u32 s53, s53, 0
  v_permlane16_swap_b32 v4, v6
  s_and_b32 s52, s52, 0xffffff80
  s_or_b32 s54, s52, 64
  s_mov_b32 s55, s53
  s_or_b32 s52, s52, s59
  v_add_f32 v213, v4, v6
  v_mov_b32 v212, v3
  v_mov_b32 v214, s52
  v_mov_b32 v215, s53
  v_mov_b32 v100, 0
  v_mov_b32 v101, 0
  v_mov_b32 v102, 0
  v_mov_b32 v103, 0
  v_mov_b32 v104, 0
  v_mov_b32 v105, 0
  v_mov_b32 v106, 0
  v_mov_b32 v107, 0
  v_mov_b32 v108, 0
  v_mov_b32 v109, 0
  v_mov_b32 v110, 0
  v_mov_b32 v111, 0
  v_mov_b32 v112, 0
  v_mov_b32 v113, 0
  v_mov_b32 v114, 0
  v_mov_b32 v115, 0
  v_mov_b32 v116, 0
  v_mov_b32 v117, 0
  v_mov_b32 v118, 0
  v_mov_b32 v119, 0
  v_mov_b32 v120, 0
  v_mov_b32 v121, 0
  v_mov_b32 v122, 0
  v_mov_b32 v123, 0
  v_mov_b32 v124, 0
  v_mov_b32 v125, 0
  v_mov_b32 v126, 0
  v_mov_b32 v127, 0
  v_mov_b32 v128, 0
  v_mov_b32 v129, 0
  v_mov_b32 v130, 0
  v_mov_b32 v131, 0
  v_subrev_u32 v204, 49152, v204
  v_subrev_u32 v205, 2048, v205
  s_bitset0_b32 s32, 0
  s_mov_b32 s48, 8192
  s_mov_b32 s51, 65
  s_mov_b32 s44, 0
  v_add_u32 v20, s48, v16
  v_add_u32 v21, s48, v17
  v_add_u32 v22, s48, v18
  v_add_u32 v23, s48, v19
L_p2:
  s_cmp_ge_u32 s44, 24
  s_cbranch_scc1 L_greg
  ds_read_b128 v[44:47], v204
  ds_read_b128 v[48:51], v204 offset:1024
  v_add_u32 v204, 2048, v204
  s_branch L_gdone
L_greg:
  s_sub_u32 s35, s44, 24
  s_lshl_b32 s35, s35, 3
  s_set_gpr_idx_on s35, gpr_idx(SRC0)
  s_nop 0
  v_mov_b32 v44, v132
  v_mov_b32 v45, v133
  v_mov_b32 v46, v134
  v_mov_b32 v47, v135
  v_mov_b32 v48, v136
  v_mov_b32 v49, v137
  v_mov_b32 v50, v138
  v_mov_b32 v51, v139
  s_set_gpr_idx_off
L_gdone:
  s_bitcmp0_b32 s32, s44
  s_cbranch_scc1 L_nors
  ds_read_b32 v8, v205
  s_waitcnt lgkmcnt(0)
  v_pk_mul_f32 v[100:101], v[100:101], v[8:9] op_sel_hi:[1,0]
  v_pk_mul_f32 v[102:103], v[102:103], v[8:9] op_sel_hi:[1,0]
  v_pk_mul_f32 v[104:105], v[104:105], v[8:9] op_sel_hi:[1,0]
  v_pk_mul_f32 v[106:107], v[106:107], v[8:9] op_sel_hi:[1,0]
  v_pk_mul_f32 v[108:109], v[108:109], v[8:9] op_sel_hi:[1,0]
  v_pk_mul_f32 v[110:111], v[110:111], v[8:9] op_sel_hi:[1,0]
  v_pk_mul_f32 v[112:113], v[112:113], v[8:9] op_sel_hi:[1,0]
  v_pk_mul_f32 v[114:115], v[114:115], v[8:9] op_sel_hi:[1,0]
  v_pk_mul_f32 v[116:117], v[116:117], v[8:9] op_sel_hi:[1,0]
  v_pk_mul_f32 v[118:119], v[118:119], v[8:9] op_sel_hi:[1,0]
  v_pk_mul_f32 v[120:121], v[120:121], v[8:9] op_sel_hi:[1,0]
  v_pk_mul_f32 v[122:123], v[122:123], v[8:9] op_sel_hi:[1,0]
  v_pk_mul_f32 v[124:125], v[124:125], v[8:9] op_sel_hi:[1,0]
  v_pk_mul_f32 v[126:127], v[126:127], v[8:9] op_sel_hi:[1,0]
  v_pk_mul_f32 v[128:129], v[128:129], v[8:9] op_sel_hi:[1,0]
  v_pk_mul_f32 v[130:131], v[130:131], v[8:9] op_sel_hi:[1,0]
L_nors:
  s_waitcnt lgkmcnt(1)
  v_readfirstlane_b32 s58, v201
  s_cmp_ge_i32 s58, s51
  s_cbranch_scc1 L_wv_ok
L_wv:
  ds_read_b32 v201, v10
  s_add_u32 s63, s63, 1
  s_cmp_gt_u32 s63, 0x4000000
  s_cbranch_scc1 L_end
  s_waitcnt lgkmcnt(0)
  v_readfirstlane_b32 s58, v201
  s_cmp_lt_i32 s58, s51
  s_cbranch_scc1 L_wv
L_wv_ok:
  ds_read_b64_tr_b16 v[68:69], v20 offset:0
  ds_read_b64_tr_b16 v[70:71], v20 offset:4096
  ds_read_b64_tr_b16 v[72:73], v20 offset:8
  ds_read_b64_tr_b16 v[74:75], v20 offset:4104
  ds_read_b64_tr_b16 v[76:77], v21 offset:0
  ds_read_b64_tr_b16 v[78:79], v21 offset:4096
  ds_read_b64_tr_b16 v[80:81], v21 offset:8
  ds_read_b64_tr_b16 v[82:83], v21 offset:4104
  v_mov_b32 v11, s51
  s_add_u32 s51, s51, 1
  s_add_u32 s48, s48, 8192
  s_cmp_eq_u32 s48, 57344
  s_cselect_b32 s48, 0, s48
  s_waitcnt lgkmcnt(6)
  v_mfma_f32_16x16x32_bf16 v[100:103], v[68:71], v[44:47], v[100:103]
  ds_read_b64_tr_b16 v[84:85], v22 offset:0
  ds_read_b64_tr_b16 v[86:87], v22 offset:4096
  s_waitcnt lgkmcnt(6)
  v_mfma_f32_16x16x32_bf16 v[104:107], v[72:75], v[44:47], v[104:107]
  ds_read_b64_tr_b16 v[88:89], v22 offset:8
  ds_read_b64_tr_b16 v[90:91], v22 offset:4104
  s_waitcnt lgkmcnt(6)
  v_mfma_f32_16x16x32_bf16 v[108:111], v[76:79], v[44:47], v[108:111]
  ds_read_b64_tr_b16 v[92:93], v23 offset:0
  ds_read_b64_tr_b16 v[94:95], v23 offset:4096
  s_waitcnt lgkmcnt(6)
  v_mfma_f32_16x16x32_bf16 v[112:115], v[80:83], v[44:47], v[112:115]
  ds_read_b64_tr_b16 v[96:97], v23 offset:8
  ds_read_b64_tr_b16 v[98:99], v23 offset:4104
  ds_read_b32 v201, v10
  s_waitcnt lgkmcnt(7)
  v_mfma_f32_16x16x32_bf16 v[116:119], v[84:87], v[44:47], v[116:119]
  v_add_u32 v20, s48, v16
  v_add_u32 v21, s48, v17
  v_add_u32 v22, s48, v18
  v_add_u32 v23, s48, v19
  s_waitcnt lgkmcnt(5)
  v_mfma_f32_16x16x32_bf16 v[120:123], v[88:91], v[44:47], v[120:123]
  s_waitcnt lgkmcnt(3)
  v_mfma_f32_16x16x32_bf16 v[124:127], v[92:95], v[44:47], v[124:127]
  s_waitcnt lgkmcnt(1)
  ds_write_b32 v200, v11
  v_mfma_f32_16x16x32_bf16 v[128:131], v[96:99], v[44:47], v[128:131]
  s_cmp_eq_u32 s44, 31
  s_cbranch_scc1 L_last
  s_waitcnt lgkmcnt(1)
  v_readfirstlane_b32 s58, v201
  s_cmp_ge_i32 s58, s51
  s_cbranch_scc1 L_ww_ok
L_ww:
  ds_read_b32 v201, v10
  s_add_u32 s63, s63, 1
  s_cmp_gt_u32 s63, 0x4000000
  s_cbranch_scc1 L_end
  s_waitcnt lgkmcnt(0)
  v_readfirstlane_b32 s58, v201
  s_cmp_lt_i32 s58, s51
  s_cbranch_scc1 L_ww
L_ww_ok:
  ds_read_b64_tr_b16 v[68:69], v20 offset:0
  ds_read_b64_tr_b16 v[70:71], v20 offset:4096
  ds_read_b64_tr_b16 v[72:73], v20 offset:8
  ds_read_b64_tr_b16 v[74:75], v20 offset:4104
  ds_read_b64_tr_b16 v[76:77], v21 offset:0
  ds_read_b64_tr_b16 v[78:79], v21 offset:4096
  ds_read_b64_tr_b16 v[80:81], v21 offset:8
  ds_read_b64_tr_b16 v[82:83], v21 offset:4104
  v_mov_b32 v11, s51
  s_add_u32 s51, s51, 1
  s_add_u32 s48, s48, 8192
  s_cmp_eq_u32 s48, 57344
  s_cselect_b32 s48, 0, s48
  s_waitcnt lgkmcnt(6)
  v_mfma_f32_16x16x32_bf16 v[100:103], v[68:71], v[48:51], v[100:103]
  ds_read_b64_tr_b16 v[84:85], v22 offset:0
  ds_read_b64_tr_b16 v[86:87], v22 offset:4096
  s_waitcnt lgkmcnt(6)
  v_mfma_f32_16x16x32_bf16 v[104:107], v[72:75], v[48:51], v[104:107]
  ds_read_b64_tr_b16 v[88:89], v22 offset:8
  ds_read_b64_tr_b16 v[90:91], v22 offset:4104
  s_waitcnt lgkmcnt(6)
  v_mfma_f32_16x16x32_bf16 v[108:111], v[76:79], v[48:51], v[108:111]
  ds_read_b64_tr_b16 v[92:93], v23 offset:0
  ds_read_b64_tr_b16 v[94:95], v23 offset:4096
  s_waitcnt lgkmcnt(6)
  v_mfma_f32_16x16x32_bf16 v[112:115], v[80:83], v[48:51], v[112:115]
  ds_read_b64_tr_b16 v[96:97], v23 offset:8
  ds_read_b64_tr_b16 v[98:99], v23 offset:4104
  ds_read_b32 v201, v10
  s_waitcnt lgkmcnt(7)
  v_mfma_f32_16x16x32_bf16 v[116:119], v[84:87], v[48:51], v[116:119]
  v_add_u32 v20, s48, v16
  v_add_u32 v21, s48, v17
  v_add_u32 v22, s48, v18
  v_add_u32 v23, s48, v19
  s_waitcnt lgkmcnt(5)
  v_mfma_f32_16x16x32_bf16 v[120:123], v[88:91], v[48:51], v[120:123]
  s_waitcnt lgkmcnt(3)
  v_mfma_f32_16x16x32_bf16 v[124:127], v[92:95], v[48:51], v[124:127]
  s_waitcnt lgkmcnt(1)
  ds_write_b32 v200, v11
  v_mfma_f32_16x16x32_bf16 v[128:131], v[96:99], v[48:51], v[128:131]
  v_add_u32 v205, 64, v205
  s_add_u32 s44, s44, 1
  s_branch L_p2
L_last:
  s_barrier
  ds_read_b64_tr_b16 v[68:69], v20 offset:0
  ds_read_b64_tr_b16 v[70:71], v20 offset:4096
  ds_read_b64_tr_b16 v[72:73], v20 offset:8
  ds_read_b64_tr_b16 v[74:75], v20 offset:4104
  ds_read_b64_tr_b16 v[76:77], v21 offset:0
  ds_read_b64_tr_b16 v[78:79], v21 offset:4096
  ds_read_b64_tr_b16 v[80:81], v21 offset:8
  ds_read_b64_tr_b16 v[82:83], v21 offset:4104
  s_waitcnt lgkmcnt(6)
  v_mfma_f32_16x16x32_bf16 v[100:103], v[68:71], v[48:51], v[100:103]
  ds_read_b64_tr_b16 v[84:85], v22 offset:0
  ds_read_b64_tr_b16 v[86:87], v22 offset:4096
  s_waitcnt lgkmcnt(6)
  v_mfma_f32_16x16x32_bf16 v[104:107], v[72:75], v[48:51], v[104:107]
  ds_read_b64_tr_b16 v[88:89], v22 offset:8
  ds_read_b64_tr_b16 v[90:91], v22 offset:4104
  s_waitcnt lgkmcnt(6)
  v_mfma_f32_16x16x32_bf16 v[108:111], v[76:79], v[48:51], v[108:111]
  ds_read_b64_tr_b16 v[92:93], v23 offset:0
  ds_read_b64_tr_b16 v[94:95], v23 offset:4096
  s_waitcnt lgkmcnt(6)
  v_mfma_f32_16x16x32_bf16 v[112:115], v[80:83], v[48:51], v[112:115]
  ds_read_b64_tr_b16 v[96:97], v23 offset:8
  ds_read_b64_tr_b16 v[98:99], v23 offset:4104
  s_waitcnt lgkmcnt(6)
  v_mfma_f32_16x16x32_bf16 v[116:119], v[84:87], v[48:51], v[116:119]
  s_waitcnt lgkmcnt(4)
  v_mfma_f32_16x16x32_bf16 v[120:123], v[88:91], v[48:51], v[120:123]
  v_cvt_pk_bf16_f32 v132, v100, v101
  v_cvt_pk_bf16_f32 v133, v102, v103
  v_cvt_pk_bf16_f32 v134, v104, v105
  v_cvt_pk_bf16_f32 v135, v106, v107
  buffer_store_dwordx4 v[132:135], v196, s[36:39], s74 offen offset:0
  s_waitcnt lgkmcnt(2)
  v_mfma_f32_16x16x32_bf16 v[124:127], v[92:95], v[48:51], v[124:127]
  v_cvt_pk_bf16_f32 v136, v108, v109
  v_cvt_pk_bf16_f32 v137, v110, v111
  v_cvt_pk_bf16_f32 v138, v112, v113
  v_cvt_pk_bf16_f32 v139, v114, v115
  buffer_store_dwordx4 v[136:139], v196, s[36:39], s74 offen offset:1024
  s_waitcnt lgkmcnt(0)
  v_mfma_f32_16x16x32_bf16 v[128:131], v[96:99], v[48:51], v[128:131]
  v_cvt_pk_bf16_f32 v140, v116, v117
  v_cvt_pk_bf16_f32 v141, v118, v119
  v_cvt_pk_bf16_f32 v142, v120, v121
  v_cvt_pk_bf16_f32 v143, v122, v123
  buffer_store_dwordx4 v[140:143], v196, s[36:39], s74 offen offset:2048
  s_nop 0
  v_cvt_pk_bf16_f32 v144, v124, v125
  v_cvt_pk_bf16_f32 v145, v126, v127
  v_cvt_pk_bf16_f32 v146, v128, v129
  v_cvt_pk_bf16_f32 v147, v130, v131
  buffer_store_dwordx4 v[144:147], v196, s[36:39], s74 offen offset:3072
  s_mov_b64 exec, -1
  s_cmp_lg_u32 s42, 0
  s_cbranch_scc1 L_own1
  v_mov_b32 v68, v132
  v_mov_b32 v69, v133
  v_mov_b32 v70, v134
  v_mov_b32 v71, v135
  v_mov_b32_dpp v72, v136 row_ror:4 row_mask:0xf bank_mask:0xf
  v_mov_b32_dpp v73, v137 row_ror:4 row_mask:0xf bank_mask:0xf
  v_mov_b32_dpp v74, v138 row_ror:4 row_mask:0xf bank_mask:0xf
  v_mov_b32_dpp v75, v139 row_ror:4 row_mask:0xf bank_mask:0xf
  v_mov_b32_dpp v76, v140 row_ror:8 row_mask:0xf bank_mask:0xf
  v_mov_b32_dpp v77, v141 row_ror:8 row_mask:0xf bank_mask:0xf
  v_mov_b32_dpp v78, v142 row_ror:8 row_mask:0xf bank_mask:0xf
  v_mov_b32_dpp v79, v143 row_ror:8 row_mask:0xf bank_mask:0xf
  v_mov_b32_dpp v80, v144 row_ror:12 row_mask:0xf bank_mask:0xf
  v_mov_b32_dpp v81, v145 row_ror:12 row_mask:0xf bank_mask:0xf
  v_mov_b32_dpp v82, v146 row_ror:12 row_mask:0xf bank_mask:0xf
  v_mov_b32_dpp v83, v147 row_ror:12 row_mask:0xf bank_mask:0xf
  s_branch L_owndone
L_own1:
  s_cmp_lg_u32 s42, 1
  s_cbranch_scc1 L_own2
  v_mov_b32 v68, v136
  v_mov_b32 v69, v137
  v_mov_b32 v70, v138
  v_mov_b32 v71, v139
  v_mov_b32_dpp v72, v140 row_ror:4 row_mask:0xf bank_mask:0xf
  v_mov_b32_dpp v73, v141 row_ror:4 row_mask:0xf bank_mask:0xf
  v_mov_b32_dpp v74, v142 row_ror:4 row_mask:0xf bank_mask:0xf
  v_mov_b32_dpp v75, v143 row_ror:4 row_mask:0xf bank_mask:0xf
  v_mov_b32_dpp v76, v144 row_ror:8 row_mask:0xf bank_mask:0xf
  v_mov_b32_dpp v77, v145 row_ror:8 row_mask:0xf bank_mask:0xf
  v_mov_b32_dpp v78, v146 row_ror:8 row_mask:0xf bank_mask:0xf
  v_mov_b32_dpp v79, v147 row_ror:8 row_mask:0xf bank_mask:0xf
  v_mov_b32_dpp v80, v132 row_ror:12 row_mask:0xf bank_mask:0xf
  v_mov_b32_dpp v81, v133 row_ror:12 row_mask:0xf bank_mask:0xf
  v_mov_b32_dpp v82, v134 row_ror:12 row_mask:0xf bank_mask:0xf
  v_mov_b32_dpp v83, v135 row_ror:12 row_mask:0xf bank_mask:0xf
  s_branch L_owndone
L_own2:
  s_cmp_lg_u32 s42, 2
  s_cbranch_scc1 L_own3
  v_mov_b32 v68, v140
  v_mov_b32 v69, v141
  v_mov_b32 v70, v142
  v_mov_b32 v71, v143
  v_mov_b32_dpp v72, v144 row_ror:4 row_mask:0xf bank_mask:0xf
  v_mov_b32_dpp v73, v145 row_ror:4 row_mask:0xf bank_mask:0xf
  v_mov_b32_dpp v74, v146 row_ror:4 row_mask:0xf bank_mask:0xf
  v_mov_b32_dpp v75, v147 row_ror:4 row_mask:0xf bank_mask:0xf
  v_mov_b32_dpp v76, v132 row_ror:8 row_mask:0xf bank_mask:0xf
  v_mov_b32_dpp v77, v133 row_ror:8 row_mask:0xf bank_mask:0xf
  v_mov_b32_dpp v78, v134 row_ror:8 row_mask:0xf bank_mask:0xf
  v_mov_b32_dpp v79, v135 row_ror:8 row_mask:0xf bank_mask:0xf
  v_mov_b32_dpp v80, v136 row_ror:12 row_mask:0xf bank_mask:0xf
  v_mov_b32_dpp v81, v137 row_ror:12 row_mask:0xf bank_mask:0xf
  v_mov_b32_dpp v82, v138 row_ror:12 row_mask:0xf bank_mask:0xf
  v_mov_b32_dpp v83, v139 row_ror:12 row_mask:0xf bank_mask:0xf
  s_branch L_owndone
L_own3:
  v_mov_b32 v68, v144
  v_mov_b32 v69, v145
  v_mov_b32 v70, v146
  v_mov_b32 v71, v147
  v_mov_b32_dpp v72, v132 row_ror:4 row_mask:0xf bank_mask:0xf
  v_mov_b32_dpp v73, v133 row_ror:4 row_mask:0xf bank_mask:0xf
  v_mov_b32_dpp v74, v134 row_ror:4 row_mask:0xf bank_mask:0xf
  v_mov_b32_dpp v75, v135 row_ror:4 row_mask:0xf bank_mask:0xf
  v_mov_b32_dpp v76, v136 row_ror:8 row_mask:0xf bank_mask:0xf
  v_mov_b32_dpp v77, v137 row_ror:8 row_mask:0xf bank_mask:0xf
  v_mov_b32_dpp v78, v138 row_ror:8 row_mask:0xf bank_mask:0xf
  v_mov_b32_dpp v79, v139 row_ror:8 row_mask:0xf bank_mask:0xf
  v_mov_b32_dpp v80, v140 row_ror:12 row_mask:0xf bank_mask:0xf
  v_mov_b32_dpp v81, v141 row_ror:12 row_mask:0xf bank_mask:0xf
  v_mov_b32_dpp v82, v142 row_ror:12 row_mask:0xf bank_mask:0xf
  v_mov_b32_dpp v83, v143 row_ror:12 row_mask:0xf bank_mask:0xf
L_owndone:
  s_waitcnt vmcnt(0)
  s_mov_b64 exec, 0xffff
  buffer_store_dwordx4 v[212:215], v197, s[36:39], s75 offen
  s_mov_b64 exec, s[66:67]
  buffer_load_dwordx4 v[28:31], v199, s[36:39], s61 offen sc1
L_q0:
  buffer_load_dwordx4 v[32:35], v199, s[36:39], s61 offen sc1
  s_waitcnt vmcnt(1)
L_c0:
  v_cmp_ne_u64 vcc, s[52:53], v[30:31]
  s_cbranch_vccz L_ok0
  v_cmp_eq_u64 vcc, s[54:55], v[30:31]
  s_cbranch_vccnz L_slow
  s_add_u32 s57, s57, 1
  s_cmp_ge_u32 s57, 96
  s_cbranch_scc1 L_slow
L_q1:
  buffer_load_dwordx4 v[28:31], v199, s[36:39], s61 offen sc1
  s_waitcnt vmcnt(1)
L_c1:
  v_cmp_ne_u64 vcc, s[52:53], v[34:35]
  s_cbranch_vccz L_ok1
  v_cmp_eq_u64 vcc, s[54:55], v[34:35]
  s_cbranch_vccnz L_slow
  s_add_u32 s57, s57, 1
  s_cmp_ge_u32 s57, 96
  s_cbranch_scc1 L_slow
  s_branch L_q0
L_ok0:
  buffer_load_dwordx4 v[68:71], v208, s[36:39], s60 offen sc1
  v_mov_b32 v212, v28
  v_mov_b32 v213, v29
  s_branch L_ready
L_ok1:
  buffer_load_dwordx4 v[68:71], v208, s[36:39], s60 offen sc1
  v_mov_b32 v212, v32
  v_mov_b32 v213, v33
L_ready:
  s_mov_b64 exec, s[68:69]
  buffer_load_dwordx4 v[72:75], v209, s[36:39], s60 offen sc1
  s_mov_b64 exec, s[70:71]
  buffer_load_dwordx4 v[76:79], v210, s[36:39], s60 offen sc1
  s_mov_b64 exec, s[72:73]
  buffer_load_dwordx4 v[80:83], v211, s[36:39], s60 offen sc1
  s_mov_b64 exec, -1
  v_max_f32_dpp v5, v212, v212 row_ror:4 row_mask:0xf bank_mask:0xf
  s_nop 1
  v_max_f32_dpp v5, v5, v5 row_ror:8 row_mask:0xf bank_mask:0xf
  v_mul_f32 v5, s46, v5
  v_fma_f32 v5, v212, s45, v5
  v_exp_f32 v5, v5
  s_nop 0
  v_mul_f32 v6, v213, v5
  s_nop 1
  v_add_f32_dpp v6, v6, v6 row_ror:4 row_mask:0xf bank_mask:0xf
  s_nop 1
  v_add_f32_dpp v6, v6, v6 row_ror:8 row_mask:0xf bank_mask:0xf
  v_rcp_f32 v6, v6
  s_nop 0
  v_mul_f32 v52, v5, v6
  s_nop 1
  v_mov_b32_dpp v54, v52 row_ror:4 row_mask:0xf bank_mask:0xf
  v_mov_b32_dpp v56, v52 row_ror:8 row_mask:0xf bank_mask:0xf
  v_mov_b32_dpp v58, v52 row_ror:12 row_mask:0xf bank_mask:0xf
  s_waitcnt vmcnt(3)
  v_lshlrev_b32 v100, 16, v68
  v_and_b32 v101, 0xffff0000, v68
  v_lshlrev_b32 v102, 16, v69
  v_and_b32 v103, 0xffff0000, v69
  v_lshlrev_b32 v104, 16, v70
  v_and_b32 v105, 0xffff0000, v70
  v_lshlrev_b32 v106, 16, v71
  v_and_b32 v107, 0xffff0000, v71
  v_pk_mul_f32 v[100:101], v[100:101], v[52:53] op_sel_hi:[1,0]
  v_pk_mul_f32 v[102:103], v[102:103], v[52:53] op_sel_hi:[1,0]
  v_pk_mul_f32 v[104:105], v[104:105], v[52:53] op_sel_hi:[1,0]
  v_pk_mul_f32 v[106:107], v[106:107], v[52:53] op_sel_hi:[1,0]
  s_waitcnt vmcnt(2)
  v_lshlrev_b32 v108, 16, v72
  v_and_b32 v109, 0xffff0000, v72
  v_lshlrev_b32 v110, 16, v73
  v_and_b32 v111, 0xffff0000, v73
  v_lshlrev_b32 v112, 16, v74
  v_and_b32 v113, 0xffff0000, v74
  v_lshlrev_b32 v114, 16, v75
  v_and_b32 v115, 0xffff0000, v75
  v_pk_fma_f32 v[100:101], v[108:109], v[54:55], v[100:101] op_sel_hi:[1,0,1]
  v_pk_fma_f32 v[102:103], v[110:111], v[54:55], v[102:103] op_sel_hi:[1,0,1]
  v_pk_fma_f32 v[104:105], v[112:113], v[54:55], v[104:105] op_sel_hi:[1,0,1]
  v_pk_fma_f32 v[106:107], v[114:115], v[54:55], v[106:107] op_sel_hi:[1,0,1]
  s_waitcnt vmcnt(1)
  v_lshlrev_b32 v116, 16, v76
  v_and_b32 v117, 0xffff0000, v76
  v_lshlrev_b32 v118, 16, v77
  v_and_b32 v119, 0xffff0000, v77
  v_lshlrev_b32 v120, 16, v78
  v_and_b32 v121, 0xffff0000, v78
  v_lshlrev_b32 v122, 16, v79
  v_and_b32 v123, 0xffff0000, v79
  v_pk_fma_f32 v[100:101], v[116:117], v[56:57], v[100:101] op_sel_hi:[1,0,1]
  v_pk_fma_f32 v[102:103], v[118:119], v[56:57], v[102:103] op_sel_hi:[1,0,1]
  v_pk_fma_f32 v[104:105], v[120:121], v[56:57], v[104:105] op_sel_hi:[1,0,1]
  v_pk_fma_f32 v[106:107], v[122:123], v[56:57], v[106:107] op_sel_hi:[1,0,1]
  s_waitcnt vmcnt(0)
  v_lshlrev_b32 v124, 16, v80
  v_and_b32 v125, 0xffff0000, v80
  v_lshlrev_b32 v126, 16, v81
  v_and_b32 v127, 0xffff0000, v81
  v_lshlrev_b32 v128, 16, v82
  v_and_b32 v129, 0xffff0000, v82
  v_lshlrev_b32 v130, 16, v83
  v_and_b32 v131, 0xffff0000, v83
  v_pk_fma_f32 v[100:101], v[124:125], v[58:59], v[100:101] op_sel_hi:[1,0,1]
  v_pk_fma_f32 v[102:103], v[126:127], v[58:59], v[102:103] op_sel_hi:[1,0,1]
  v_pk_fma_f32 v[104:105], v[128:129], v[58:59], v[104:105] op_sel_hi:[1,0,1]
  v_pk_fma_f32 v[106:107], v[130:131], v[58:59], v[106:107] op_sel_hi:[1,0,1]
  v_cvt_pk_bf16_f32 v60, v100, v101
  v_cvt_pk_bf16_f32 v61, v102, v103
  v_cvt_pk_bf16_f32 v62, v104, v105
  v_cvt_pk_bf16_f32 v63, v106, v107
  buffer_store_dwordx4 v[60:63], v198, s[28:31], s33 offen
  s_cmp_lg_u32 s42, 0
  s_cbranch_scc1 L_fin
  s_mov_b64 exec, 1
  buffer_store_dwordx2 v[214:215], off, s[36:39], s56
L_fin:
L_end:
  s_endpgm
L_slow:
  s_waitcnt vmcnt(0)
  s_mov_b64 exec, -1
  buffer_store_dwordx4 v[132:135], v196, s[36:39], s74 offen offset:0 sc1
  buffer_store_dwordx4 v[136:139], v196, s[36:39], s74 offen offset:1024 sc1
  buffer_store_dwordx4 v[140:143], v196, s[36:39], s74 offen offset:2048 sc1
  buffer_store_dwordx4 v[144:147], v196, s[36:39], s74 offen offset:3072 sc1
  v_mov_b32 v214, s54
  s_waitcnt vmcnt(0)
  s_mov_b64 exec, 0xffff
  buffer_store_dwordx4 v[212:215], v197, s[36:39], s75 offen sc1
  s_mov_b64 exec, s[66:67]
L_sp:
  buffer_load_dwordx4 v[28:31], v199, s[36:39], s61 offen sc1
  s_add_u32 s57, s57, 1
  s_cmp_gt_u32 s57, 0x400000
  s_cbranch_scc1 L_end
  s_waitcnt vmcnt(0)
  v_cmp_ne_u64 vcc, s[52:53], v[30:31]
  v_cmp_ne_u64 s[64:65], s[54:55], v[30:31]
  s_and_b64 vcc, vcc, s[64:65]
  s_cbranch_scc1 L_sp
  s_branch L_ok0
L_mon:
  v_and_b32 v0, 63, v0
  v_lshlrev_b32 v1, 2, v0
  v_add_u32 v2, 160512, v1
  v_mov_b32 v4, 159744
  s_and_b32 s49, s2, 7
  s_lshl_b32 s56, s49, 8
  s_add_u32 s56, s56, 524288
  s_lshl_b32 s60, s49, 7
  s_add_u32 s60, s60, 262144
  s_lshr_b32 s49, s2, 3
  s_lshl2_add_u32 s74, s49, s60
  s_waitcnt lgkmcnt(0)
  s_mov_b32 s36, s14
  s_and_b32 s37, s15, 0xffff
  s_mov_b32 s38, 0x1000000
  s_mov_b32 s39, 0x20000
  s_mov_b64 exec, 1
  buffer_load_dword v5, off, s[36:39], s56 nt
  s_mov_b64 exec, 0xffffffff
  buffer_load_dword v6, v1, s[36:39], s60 offen nt
  buffer_load_dword v6, v1, s[36:39], s60 offen sc1
  s_mov_b32 s51, 16
  s_mov_b32 s63, 0
  s_waitcnt vmcnt(0)
  v_readfirstlane_b32 s52, v5
  s_add_u32 s52, s52, 128
  s_and_b32 s52, s52, 0xffffff80
  s_getreg_b32 s59, hwreg(HW_REG_XCC_ID)
  s_and_b32 s59, s59, 7
  s_lshl_b32 s59, s59, 2
  s_lshr_b32 s59, 0x6a6a6a6a, s59
  s_and_b32 s59, s59, 15
  s_sub_i32 s59, s59, 8
L_mw:
  ds_read_b32 v5, v4
  s_add_u32 s63, s63, 1
  s_cmp_gt_u32 s63, 0x4000000
  s_cbranch_scc1 L_end
  s_waitcnt lgkmcnt(0)
  v_readfirstlane_b32 s58, v5
  s_cmp_lt_i32 s58, s51
  s_cbranch_scc1 L_mw
  s_cmp_gt_i32 s58, 120
  s_cbranch_scc1 L_end
  s_add_u32 s49, s52, s51
  v_mov_b32 v5, s49
  s_mov_b64 exec, 1
  buffer_store_dword v5, off, s[36:39], s74
  s_mov_b64 exec, 0xffffffff
  buffer_load_dword v6, v1, s[36:39], s60 offen sc1
  s_waitcnt vmcnt(0)
  v_subrev_u32 v6, s52, v6
  v_cmp_le_u32 vcc, s51, v6
  s_bcnt1_i32_b64 s49, vcc
  s_add_i32 s49, s49, s59
  v_cmp_lt_u32 vcc, 0x7f, v6
  s_cmp_ge_i32 s49, 20
  s_cselect_b32 s50, 1, 0
  s_cmp_le_i32 s49, 12
  s_cselect_b32 s50, 2, s50
  s_cmp_lg_u64 vcc, 0
  s_cselect_b32 s50, 0, s50
  s_mov_b64 exec, -1
  v_mov_b32 v3, s50
  ds_write_b32 v2, v3
  s_add_u32 s51, s51, 4
  s_cmp_le_u32 s51, 120
  s_cbranch_scc1 L_mw
  s_endpgm
.section .rodata,"a"
.p2align 6
.amdhsa_kernel standalone__gqa_softmax__sampling_kernel
  .amdhsa_next_free_vgpr 216
  .amdhsa_next_free_sgpr 76
  .amdhsa_accum_offset 216
  .amdhsa_group_segment_fixed_size 0
  .amdhsa_kernarg_size 48
  .amdhsa_user_sgpr_count 2
  .amdhsa_user_sgpr_kernarg_segment_ptr 1
  .amdhsa_system_sgpr_workgroup_id_x 1
.end_amdhsa_kernel
```
